```python
import torch

def _softmax(x, axis=-1):
    return torch.softmax(x, dim=axis)
def _gelu(x):
    return torch.nn.functional.gelu(x, approximate="tanh")
def _silu(x):
    return torch.nn.functional.silu(x)
def _sigmoid(x):
    return torch.sigmoid(x)
def _layernorm(x, axis=-1, eps=1e-5):
    m = x.mean(dim=axis, keepdim=True)
    v = x.var(dim=axis, keepdim=True, unbiased=False)
    return (x - m) / torch.sqrt(v + eps)
def _scatter_add(tgt, idx, src, axis=0):
    return tgt.clone().index_add_(axis, idx, src)
def _segment_sum(src, seg, n):
    out = torch.zeros((n,) + src.shape[1:], dtype=src.dtype)
    return out.index_add_(0, seg, src)
def _pad(x, pw):
    flat = tuple(v for pair in reversed(pw) for v in pair)
    return torch.nn.functional.pad(x, flat)

kernel_name = 'concat_heads__sliding_block_cached__gqa_block_cached__decode'

def setup_inputs():

    _w = (lambda a: (lambda t: t.to(torch.bfloat16) if t.is_floating_point() else t)(torch.as_tensor(a)))
    def _A_setup():
        B, Sq, D = 8, 1, 512
        Hq, Hkv, Sk, Dh = 32, 8, 8192, 128
        assert Hq % Hkv == 0, (Hq, Hkv)
        return {
            "x": _w((lambda *s: torch.randn(*s, dtype=torch.bfloat16) * 0.8)(B, Sq, D)),
            "k_cache": _w((lambda *s: torch.randn(*s, dtype=torch.bfloat16) * 1.6)(B, Hkv, Sk, Dh)),
            "v_cache": _w((lambda *s: torch.randn(*s, dtype=torch.bfloat16) * 0.2)(B, Hkv, Sk, Dh)),
            "wq": _w((lambda *s: torch.randn(*s, dtype=torch.bfloat16) * 1.6)(D, Hq * Dh) * (D ** -0.5)),
            "wo": _w((lambda *s: torch.randn(*s, dtype=torch.bfloat16) * 0.2)(Hq * Dh, D) * ((Hq * Dh) ** -0.5)),
        }
    _A_in = _A_setup()

    def _B_setup():
        B, Sq, D = 8, 1, 512
        Hq, Hkv, Sk, Dh = 32, 8, 8192, 128
        assert Hq % Hkv == 0, (Hq, Hkv)
        return {
            "x": _w((lambda *s: torch.randn(*s, dtype=torch.bfloat16) * 0.8)(B, Sq, D)),
            "k_cache": _w((lambda *s: torch.randn(*s, dtype=torch.bfloat16) * 1.6)(B, Hkv, Sk, Dh)),
            "v_cache": _w((lambda *s: torch.randn(*s, dtype=torch.bfloat16) * 0.2)(B, Hkv, Sk, Dh)),
            "wq": _w((lambda *s: torch.randn(*s, dtype=torch.bfloat16) * 1.6)(D, Hq * Dh) * (D ** -0.5)),
            "wo": _w((lambda *s: torch.randn(*s, dtype=torch.bfloat16) * 0.2)(Hq * Dh, D) * ((Hq * Dh) ** -0.5)),
        }
    _B_in = _B_setup()

    return {
        "A_x": _A_in["x"],
        "A_k_cache": _A_in["k_cache"],
        "A_v_cache": _A_in["v_cache"],
        "A_wq": _A_in["wq"],
        "A_wo": _A_in["wo"],
        "B_x": _B_in["x"],
        "B_k_cache": _B_in["k_cache"],
        "B_v_cache": _B_in["v_cache"],
        "B_wq": _B_in["wq"],
        "B_wo": _B_in["wo"],
    }

def reference(A_x, A_k_cache, A_v_cache, A_wq, A_wo, B_x, B_k_cache, B_v_cache, B_wq, B_wo):
    def _A_ref(x, k_cache, v_cache, wq, wo):
        B, Sq, D = x.shape
        Hq, Dh = 32, 128
        Hkv, Sk = k_cache.shape[1], k_cache.shape[2]
        W = min(4096, max(256, Sk // 4))
        rep = Hq // Hkv
        q = (lambda x, *d: x.permute(*d))((x @ wq).reshape(B, Sq, Hq, Dh), 0, 2, 1, 3)
        k = (lambda x, n, axis: torch.repeat_interleave(x, n, dim=axis))(k_cache[:, :, Sk - W:, :], rep, axis=1)
        v = (lambda x, n, axis: torch.repeat_interleave(x, n, dim=axis))(v_cache[:, :, Sk - W:, :], rep, axis=1)
        scores = torch.einsum("bhqd,bhkd->bhqk", q, k) * (Dh ** -0.5)
        p = _softmax(scores, axis=-1)
        o = torch.einsum("bhqk,bhkd->bhqd", p, v)
        return (lambda x, *d: x.permute(*d))(o, 0, 2, 1, 3).reshape(B, Sq, Hq * Dh) @ wo

    def _B_ref(x, k_cache, v_cache, wq, wo):
        B, Sq, D = x.shape
        Hq, Dh = 32, 128
        Hkv = k_cache.shape[1]
        rep = Hq // Hkv
        q = (lambda x, *d: x.permute(*d))((x @ wq).reshape(B, Sq, Hq, Dh), 0, 2, 1, 3)
        k = (lambda x, n, axis: torch.repeat_interleave(x, n, dim=axis))(k_cache, rep, axis=1)
        v = (lambda x, n, axis: torch.repeat_interleave(x, n, dim=axis))(v_cache, rep, axis=1)
        scores = torch.einsum("bhqd,bhkd->bhqk", q, k) * (Dh ** -0.5)
        p = _softmax(scores, axis=-1)
        o = torch.einsum("bhqk,bhkd->bhqd", p, v)
        return (lambda x, *d: x.permute(*d))(o, 0, 2, 1, 3).reshape(B, Sq, Hq * Dh) @ wo

    a = _A_ref(A_x, A_k_cache, A_v_cache, A_wq, A_wo)
    b = _B_ref(B_x, B_k_cache, B_v_cache, B_wq, B_wo)
    return torch.concatenate([a, b], axis=-1)
```

```asm
; @launch grid=(256,1,1) block=(256,1,1) lds=143616
.amdgcn_target "amdgcn-amd-amdhsa--gfx950"
.text
.globl concat_heads__sliding_block_cached__gqa_block_cached__decode_kernel
.p2align 8
.type concat_heads__sliding_block_cached__gqa_block_cached__decode_kernel,@function
concat_heads__sliding_block_cached__gqa_block_cached__decode_kernel:
  s_cmp_ge_u32 s2, 256
  s_cbranch_scc1 L_end
  s_load_dwordx16 s[4:19], s[0:1], 0
  s_load_dwordx8 s[20:27], s[0:1], 64
  s_load_dwordx2 s[28:29], s[0:1], 96
  s_getpc_b64 s[50:51]
L_pc:
  s_lshr_b32 s54, s2, 3
  s_lshl_b32 s54, s54, 9
  v_and_b32 v198, 3, v0
  v_lshlrev_b32 v198, 7, v198
  v_add_u32 v198, s54, v198
  v_min_u32 v198, L_end-L_pc, v198
  v_cmp_gt_u32 vcc, 4, v0
  s_and_saveexec_b64 s[64:65], vcc
  s_cbranch_execz L_nopf
  global_load_dword v198, v198, s[50:51]
L_nopf:
  s_mov_b64 exec, s[64:65]
  v_and_b32 v1, 63, v0
  v_lshrrev_b32 v164, 6, v0
  v_and_b32 v2, 15, v0
  v_readfirstlane_b32 s30, v164
  v_lshrrev_b32 v3, 4, v1
  s_lshr_b32 s54, s2, 3
  s_and_b32 s55, s2, 7
  s_mov_b32 s56, 2
  s_and_b32 s31, s55, s56
  s_bcnt1_i32_b32 s31, s31
  s_and_b32 s31, s31, 1
  s_lshl_b32 s54, s54, 1
  s_add_u32 s31, s31, s54
  s_ff1_i32_b32 s56, s56
  s_lshl_b32 s54, 1, s56
  s_sub_u32 s54, s54, 1
  s_and_b32 s54, s54, s55
  s_add_u32 s32, s56, 1
  s_lshr_b32 s32, s55, s32
  s_lshl_b32 s32, s32, s56
  s_or_b32 s32, s32, s54
  s_lshr_b32 s33, s31, 3
  s_and_b32 s34, s31, 7
  s_mul_i32 s48, s30, 24576
  s_lshr_b32 s84, s33, 2
  s_bfe_u32 s86, s33, 0x10001
  s_and_b32 s54, s33, 1
  s_lshl_b32 s54, s54, 2
  s_add_u32 s54, s54, s32
  s_lshl_b32 s85, s34, 3
  s_add_u32 s85, s85, s54
  v_and_b32 v172, 7, v1
  v_lshlrev_b32 v172, 10, v172
  v_lshl_add_u32 v172, v3, 4, v172
  s_lshl_b32 s55, s86, 9
  s_lshl_b32 s54, s30, 7
  s_add_u32 s55, s55, s54
  v_add_u32 v172, s55, v172
  v_lshrrev_b32 v173, 3, v1
  v_lshlrev_b32 v173, 13, v173
  v_and_b32 v166, 7, v1
  v_lshl_add_u32 v173, v166, 4, v173
  s_lshl_b32 s54, s85, 7
  s_lshl_b32 s55, s86, 21
  s_add_u32 s54, s54, s55
  s_lshl_b32 s55, s30, 19
  s_add_u32 s56, s54, s55
  s_waitcnt lgkmcnt(0)
  s_load_dword s35, s[28:29], 0
  s_cmp_eq_u32 s84, 0
  s_cselect_b32 s50, s4, s14
  s_cselect_b32 s51, s5, s15
  s_cselect_b32 s52, s10, s20
  s_cselect_b32 s53, s11, s21
  s_add_u32 s52, s52, s56
  s_addc_u32 s53, s53, 0
  s_lshl_b32 s54, s31, 8
  s_add_u32 s54, s54, 1064960
  s_add_u32 s46, s28, s54
  s_addc_u32 s47, s29, 0
  s_or_b32 s55, s32, s30
  s_cmp_lg_u32 s55, 0
  s_cbranch_scc1 L_noinit_1
  v_mov_b32 v164, 0
  v_mov_b32 v165, 576
  global_store_dword v164, v165, s[46:47] sc1
L_noinit_1:
  global_load_dwordx4 v[56:59], v172, s[50:51] offset:0
  global_load_dwordx4 v[60:63], v172, s[50:51] offset:64
  s_add_u32 s56, s48, 16384
  s_add_u32 m0, s56, 0
  s_nop 0
  global_load_lds_dwordx4 v173, s[52:53] nt
  s_add_u32 m0, s56, 1024
  s_add_u32 s52, s52, 65536
  s_addc_u32 s53, s53, 0
  global_load_lds_dwordx4 v173, s[52:53] nt
  s_add_u32 m0, s56, 2048
  s_add_u32 s52, s52, 65536
  s_addc_u32 s53, s53, 0
  global_load_lds_dwordx4 v173, s[52:53] nt
  s_add_u32 m0, s56, 3072
  s_add_u32 s52, s52, 65536
  s_addc_u32 s53, s53, 0
  global_load_lds_dwordx4 v173, s[52:53] nt
  s_add_u32 m0, s56, 4096
  s_add_u32 s52, s52, 65536
  s_addc_u32 s53, s53, 0
  global_load_lds_dwordx4 v173, s[52:53] nt
  s_add_u32 m0, s56, 5120
  s_add_u32 s52, s52, 65536
  s_addc_u32 s53, s53, 0
  global_load_lds_dwordx4 v173, s[52:53] nt
  s_add_u32 m0, s56, 6144
  s_add_u32 s52, s52, 65536
  s_addc_u32 s53, s53, 0
  global_load_lds_dwordx4 v173, s[52:53] nt
  s_add_u32 m0, s56, 7168
  s_add_u32 s52, s52, 65536
  s_addc_u32 s53, s53, 0
  global_load_lds_dwordx4 v173, s[52:53] nt
  v_xor_b32 v164, v2, v3
  v_lshlrev_b32 v164, 4, v164
  v_lshl_add_u32 v4, v3, 8, v164
  v_xor_b32 v5, 0x40, v4
  v_xor_b32 v6, 0x80, v4
  v_xor_b32 v7, 0xc0, v4
  v_lshlrev_b32 v164, 1, v3
  v_xor_b32 v164, v2, v164
  v_lshlrev_b32 v164, 4, v164
  v_lshl_add_u32 v8, v3, 8, v164
  v_xor_b32 v9, 0x80, v8
  s_lshl_b32 s54, s31, 21
  s_add_u32 s38, s16, s54
  s_addc_u32 s39, s17, 0
  s_add_u32 s40, s18, s54
  s_addc_u32 s41, s19, 0
  s_add_u32 s42, s6, s54
  s_addc_u32 s43, s7, 0
  s_sub_u32 s42, s42, 0x80000
  s_subb_u32 s43, s43, 0
  s_add_u32 s44, s8, s54
  s_addc_u32 s45, s9, 0
  s_sub_u32 s44, s44, 0x80000
  s_subb_u32 s45, s45, 0
  s_add_u32 s80, s48, 24576
  s_mov_b32 s72, s48
  s_add_u32 s73, s48, 4096
  s_lshl_b32 s70, s32, 2
  s_add_u32 s70, s70, s30
  s_lshl_b32 s54, s70, 12
  s_add_u32 s50, s38, s54
  s_addc_u32 s51, s39, 0
  s_mov_b32 m0, s72
  s_add_u32 s72, s72, 8192
  global_load_lds_dwordx4 v4, s[50:51] offset:0 nt
  global_load_lds_dwordx4 v5, s[50:51] offset:1024 nt
  global_load_lds_dwordx4 v6, s[50:51] offset:2048 nt
  global_load_lds_dwordx4 v7, s[50:51] offset:3072 nt
  s_cmp_ge_u32 s72, s80
  s_cselect_b32 s54, 24576, 0
  s_sub_u32 s72, s72, s54
  s_lshl_b32 s54, s70, 12
  s_add_u32 s50, s40, s54
  s_addc_u32 s51, s41, 0
  s_mov_b32 m0, s73
  s_add_u32 s73, s73, 8192
  global_load_lds_dwordx4 v8, s[50:51] offset:0 nt
  global_load_lds_dwordx4 v9, s[50:51] offset:1024 nt
  global_load_lds_dwordx4 v8, s[50:51] offset:2048 nt
  global_load_lds_dwordx4 v9, s[50:51] offset:3072 nt
  s_cmp_ge_u32 s73, s80
  s_cselect_b32 s54, 24576, 0
  s_sub_u32 s73, s73, s54
  v_lshrrev_b32 v164, 2, v2
  v_lshl_add_u32 v164, v3, 3, v164
  v_lshlrev_b32 v164, 7, v164
  v_and_b32 v165, 3, v2
  v_lshl_add_u32 v164, v165, 3, v164
  s_add_u32 s56, s48, 16384
  v_add_u32 v164, s56, v164
  s_mov_b32 s57, 0x3db504f3
  s_mov_b32 s58, 0x3fb8aa3b
  v_mov_b32 v199, 0xffff0000
  v_mov_b32 v200, 0xfffff000
  v_xor_b32 v168, v2, v3
  v_lshlrev_b32 v168, 4, v168
  v_lshl_add_u32 v168, v2, 8, v168
  v_xor_b32 v169, 0x0, v168
  v_add_u32 v10, s48, v169
  v_xor_b32 v169, 0x40, v168
  v_add_u32 v11, s48, v169
  v_xor_b32 v169, 0x80, v168
  v_add_u32 v12, s48, v169
  v_xor_b32 v169, 0xc0, v168
  v_add_u32 v13, s48, v169
  v_lshrrev_b32 v168, 2, v2
  v_lshl_add_u32 v169, v3, 2, v168
  v_and_b32 v170, 1, v3
  v_lshlrev_b32 v170, 3, v170
  v_lshl_add_u32 v170, v168, 1, v170
  v_bfe_u32 v171, v2, 1, 1
  v_add_u32 v170, v170, v171
  v_lshlrev_b32 v170, 4, v170
  v_lshl_add_u32 v170, v169, 8, v170
  v_and_b32 v171, 1, v2
  v_lshl_add_u32 v196, v171, 3, v170
  s_add_u32 s54, s48, 4096
  v_xor_b32 v171, 0x0, v196
  v_add_u32 v14, s54, v171
  v_xor_b32 v171, 0x20, v196
  v_add_u32 v15, s54, v171
  v_xor_b32 v171, 0x40, v196
  v_add_u32 v16, s54, v171
  v_xor_b32 v171, 0x60, v196
  v_add_u32 v17, s54, v171
  v_xor_b32 v171, 0x80, v196
  v_add_u32 v18, s54, v171
  v_xor_b32 v171, 0xa0, v196
  v_add_u32 v19, s54, v171
  v_xor_b32 v171, 0xc0, v196
  v_add_u32 v20, s54, v171
  v_xor_b32 v171, 0xe0, v196
  v_add_u32 v21, s54, v171
  s_lshr_b32 s60, s2, 7
  s_bfe_u32 s62, s2, 0x20003
  s_bfe_u32 s61, s2, 0x20005
  s_lshl_b32 s61, s61, 3
  s_and_b32 s54, s2, 7
  s_add_u32 s61, s61, s54
  v_mul_u32_u24 v169, 528, v2
  v_lshl_add_u32 v169, v3, 4, v169
  v_add_u32 v209, s48, v169
  s_add_u32 s54, s48, 4352
  v_lshlrev_b32 v169, 3, v2
  v_add_u32 v210, s54, v169
  v_lshrrev_b32 v169, 5, v0
  v_and_b32 v170, 31, v0
  v_mul_u32_u24 v171, 528, v169
  v_lshl_add_u32 v211, v170, 4, v171
  v_add_u32 v212, 73728, v211
  v_lshlrev_b32 v171, 3, v169
  v_add_u32 v213, 4352, v171
  v_add_u32 v214, 73728, v213
  v_lshrrev_b32 v171, 7, v0
  v_lshlrev_b32 v215, 19, v171
  v_and_b32 v171, 127, v0
  v_lshl_add_u32 v215, v171, 4, v215
  s_lshl_b32 s54, s31, 13
  s_lshl_b32 s55, s32, 11
  s_add_u32 s54, s54, s55
  s_add_u32 s54, s54, 1114112
  v_add_u32 v215, s54, v215
  v_lshrrev_b32 v171, 7, v0
  v_lshlrev_b32 v216, 16, v171
  v_bfe_u32 v171, v0, 6, 1
  v_lshl_add_u32 v216, v171, 7, v216
  v_bfe_u32 v171, v0, 5, 1
  v_lshl_add_u32 v216, v171, 3, v216
  s_lshl_b32 s54, s31, 10
  s_lshl_b32 s55, s32, 8
  s_add_u32 s54, s54, s55
  s_add_u32 s54, s54, 2162688
  v_add_u32 v216, s54, v216
  v_lshl_add_u32 v171, v3, 10, v196
  s_lshl_b32 s54, s30, 6
  v_xor_b32 v171, s54, v171
  v_add_u32 v218, 98304, v171
  v_xor_b32 v219, 0x20, v218
  s_lshr_b32 s54, s61, 2
  s_and_b32 s55, s61, 3
  s_lshl_b32 s56, s60, 19
  s_lshl_b32 s50, s54, 13
  s_add_u32 s56, s56, s50
  s_lshl_b32 s50, s55, 9
  s_add_u32 s56, s56, s50
  s_add_u32 s56, s56, 1114112
  v_lshlrev_b32 v171, 4, v170
  v_lshl_add_u32 v171, v169, 16, v171
  v_add_u32 v220, s56, v171
  v_add_u32 v221, 4096, v220
  s_lshl_b32 s56, s60, 16
  s_lshl_b32 s50, s54, 10
  s_add_u32 s56, s56, s50
  s_lshr_b32 s50, s55, 1
  s_lshl_b32 s50, s50, 7
  s_add_u32 s56, s56, s50
  s_and_b32 s50, s55, 1
  s_lshl_b32 s50, s50, 3
  s_add_u32 s56, s56, s50
  s_add_u32 s56, s56, 2162688
  v_lshlrev_b32 v171, 13, v169
  v_add_u32 v217, s56, v171
  v_mul_u32_u24 v171, 272, v169
  v_lshl_add_u32 v171, v170, 3, v171
  v_add_u32 v222, 141312, v171
  v_and_b32 v171, 7, v1
  v_mul_u32_u24 v171, 272, v171
  v_lshl_add_u32 v171, v3, 4, v171
  v_add_u32 v223, 141312, v171
  s_lshl_b32 s54, s60, 19
  s_lshl_b32 s55, s61, 14
  s_add_u32 s54, s54, s55
  s_lshl_b32 s55, s62, 9
  s_add_u32 s54, s54, s55
  s_lshl_b32 s55, s30, 7
  s_add_u32 s54, s54, s55
  s_add_u32 s54, s54, 2359296
  v_and_b32 v171, 7, v2
  v_lshlrev_b32 v171, 11, v171
  v_lshl_add_u32 v171, v3, 4, v171
  v_lshrrev_b32 v170, 3, v2
  v_lshl_add_u32 v171, v170, 6, v171
  v_add_u32 v224, s54, v171
  s_bfe_u32 s54, s2, 0x30004
  s_and_b32 s55, s2, 15
  s_lshl_b32 s56, s60, 19
  s_lshl_b32 s50, s54, 11
  s_add_u32 s56, s56, s50
  s_lshl_b32 s50, s55, 7
  s_add_u32 s56, s56, s50
  s_add_u32 s56, s56, 2359296
  v_lshrrev_b32 v171, 3, v1
  v_lshlrev_b32 v171, 14, v171
  v_and_b32 v170, 7, v1
  v_lshl_add_u32 v171, v170, 4, v171
  v_add_u32 v225, s56, v171
  v_add_u32 v226, 0x20000, v225
  v_add_u32 v227, 0x40000, v225
  v_add_u32 v228, 0x60000, v225
  s_lshl_b32 s56, s54, 11
  s_lshl_b32 s50, s60, 10
  s_add_u32 s56, s56, s50
  s_lshl_b32 s50, s55, 6
  s_add_u32 s56, s56, s50
  v_lshlrev_b32 v171, 3, v1
  v_add_u32 v229, s56, v171
  s_waitcnt vmcnt(8)
  ds_read_b64_tr_b16 v[96:97], v164 offset:0
  ds_read_b64_tr_b16 v[98:99], v164 offset:512
  ds_read_b64_tr_b16 v[100:101], v164 offset:4096
  ds_read_b64_tr_b16 v[102:103], v164 offset:4608
  ds_read_b64_tr_b16 v[104:105], v164 offset:32
  ds_read_b64_tr_b16 v[106:107], v164 offset:544
  ds_read_b64_tr_b16 v[108:109], v164 offset:4128
  ds_read_b64_tr_b16 v[110:111], v164 offset:4640
  ds_read_b64_tr_b16 v[112:113], v164 offset:64
  ds_read_b64_tr_b16 v[114:115], v164 offset:576
  ds_read_b64_tr_b16 v[116:117], v164 offset:4160
  ds_read_b64_tr_b16 v[118:119], v164 offset:4672
  ds_read_b64_tr_b16 v[120:121], v164 offset:96
  ds_read_b64_tr_b16 v[122:123], v164 offset:608
  ds_read_b64_tr_b16 v[124:125], v164 offset:4192
  ds_read_b64_tr_b16 v[126:127], v164 offset:4704
  v_and_b32 v165, 7, v1
  v_lshlrev_b32 v165, 8, v165
  v_lshl_add_u32 v165, v3, 4, v165
  s_lshl_b32 s54, s30, 11
  s_add_u32 s54, s54, 131072
  v_add_u32 v165, s54, v165
  s_waitcnt lgkmcnt(0)
  v_mfma_f32_16x16x32_bf16 v[168:171], v[96:99], v[56:59], 0
  v_mfma_f32_16x16x32_bf16 v[172:175], v[104:107], v[56:59], 0
  v_mfma_f32_16x16x32_bf16 v[176:179], v[112:115], v[56:59], 0
  v_mfma_f32_16x16x32_bf16 v[180:183], v[120:123], v[56:59], 0
  v_mfma_f32_16x16x32_bf16 v[168:171], v[100:103], v[60:63], v[168:171]
  v_mfma_f32_16x16x32_bf16 v[172:175], v[108:111], v[60:63], v[172:175]
  v_mfma_f32_16x16x32_bf16 v[176:179], v[116:119], v[60:63], v[176:179]
  v_mfma_f32_16x16x32_bf16 v[180:183], v[124:127], v[60:63], v[180:183]
  s_add_u32 s70, s70, 16
  s_lshl_b32 s54, s70, 12
  s_add_u32 s50, s38, s54
  s_addc_u32 s51, s39, 0
  s_mov_b32 m0, s72
  s_add_u32 s72, s72, 8192
  global_load_lds_dwordx4 v4, s[50:51] offset:0 nt
  global_load_lds_dwordx4 v5, s[50:51] offset:1024 nt
  global_load_lds_dwordx4 v6, s[50:51] offset:2048 nt
  global_load_lds_dwordx4 v7, s[50:51] offset:3072 nt
  s_cmp_ge_u32 s72, s80
  s_cselect_b32 s54, 24576, 0
  s_sub_u32 s72, s72, s54
  s_lshl_b32 s54, s70, 12
  s_add_u32 s50, s40, s54
  s_addc_u32 s51, s41, 0
  s_mov_b32 m0, s73
  s_add_u32 s73, s73, 8192
  global_load_lds_dwordx4 v8, s[50:51] offset:0 nt
  global_load_lds_dwordx4 v9, s[50:51] offset:1024 nt
  global_load_lds_dwordx4 v8, s[50:51] offset:2048 nt
  global_load_lds_dwordx4 v9, s[50:51] offset:3072 nt
  s_cmp_ge_u32 s73, s80
  s_cselect_b32 s54, 24576, 0
  s_sub_u32 s73, s73, s54
  ds_write_b128 v165, v[168:171] offset:0
  ds_write_b128 v165, v[172:175] offset:64
  ds_write_b128 v165, v[176:179] offset:128
  ds_write_b128 v165, v[180:183] offset:192
  s_waitcnt lgkmcnt(0)
  s_add_u32 s35, s35, 1
  s_and_b32 s36, s35, 0xffff
  v_mov_b32 v205, s36
  v_xor_b32 v206, 0x5555, v205
  v_xor_b32 v207, 0xaaaa, v205
  v_xor_b32 v208, 0xffff, v205
  v_and_b32 v201, 0xfff, v205
  v_and_b32 v202, 0xfff, v206
  v_and_b32 v203, 0xfff, v207
  v_and_b32 v204, 0xfff, v208
  v_mov_b32 v188, s35
  v_xor_b32 v189, 0x55555555, v188
  s_and_b32 s54, s35, 31
  s_xor_b32 s55, s54, 0
  v_mov_b32 v188, s55
  s_xor_b32 s55, s54, 21
  v_mov_b32 v189, s55
  s_xor_b32 s55, s54, 10
  v_mov_b32 v190, s55
  s_xor_b32 s55, s54, 31
  v_mov_b32 v191, s55
  s_xor_b32 s55, s54, 6
  v_mov_b32 v192, s55
  s_xor_b32 s55, s54, 19
  v_mov_b32 v193, s55
  s_xor_b32 s55, s54, 12
  v_mov_b32 v194, s55
  s_xor_b32 s55, s54, 25
  v_mov_b32 v195, s55
  v_and_b32 v187, 1, v1
  v_cmp_eq_u32 vcc, 1, v187
  s_nop 1
  v_cndmask_b32 v88, v188, v192, vcc
  v_cndmask_b32 v89, v189, v193, vcc
  v_cndmask_b32 v90, v190, v194, vcc
  v_cndmask_b32 v91, v191, v195, vcc
  s_barrier
  s_cmp_gt_u32 s30, 1
  s_cbranch_scc1 L_nopub_2
  v_and_b32 v164, 127, v0
  v_lshlrev_b32 v164, 4, v164
  v_add_u32 v164, 131072, v164
  ds_read_b128 v[168:171], v164 offset:0
  ds_read_b128 v[172:175], v164 offset:2048
  ds_read_b128 v[176:179], v164 offset:4096
  ds_read_b128 v[180:183], v164 offset:6144
  s_lshl_b32 s54, s86, 18
  s_lshl_b32 s55, s84, 17
  s_add_u32 s54, s54, s55
  s_lshl_b32 s55, s85, 8
  s_add_u32 s54, s54, s55
  s_add_u32 s54, s54, 4096
  v_bfe_u32 v165, v0, 4, 3
  v_lshlrev_b32 v165, 14, v165
  v_lshl_add_u32 v165, v2, 4, v165
  v_add_u32 v165, s54, v165
  v_mov_b32 v166, 0xffffffe0
  s_waitcnt lgkmcnt(0)
  v_add_f32 v168, v168, v172
  v_add_f32 v176, v176, v180
  v_add_f32 v169, v169, v173
  v_add_f32 v177, v177, v181
  v_add_f32 v170, v170, v174
  v_add_f32 v178, v178, v182
  v_add_f32 v171, v171, v175
  v_add_f32 v179, v179, v183
  v_add_f32 v168, v168, v176
  v_add_f32 v169, v169, v177
  v_add_f32 v170, v170, v178
  v_add_f32 v171, v171, v179
  v_add_u32 v168, 0x10, v168
  v_add_u32 v169, 0x10, v169
  v_add_u32 v170, 0x10, v170
  v_add_u32 v171, 0x10, v171
  v_and_or_b32 v176, v168, v166, v88
  v_and_or_b32 v177, v169, v166, v89
  v_and_or_b32 v178, v170, v166, v90
  v_and_or_b32 v179, v171, v166, v91
  global_store_dwordx4 v165, v[176:179], s[28:29] sc1
L_nopub_2:
  v_lshrrev_b32 v170, 7, v0
  v_lshlrev_b32 v170, 17, v170
  v_bfe_u32 v171, v0, 1, 6
  v_lshl_add_u32 v170, v171, 5, v170
  v_and_b32 v171, 1, v0
  v_lshl_add_u32 v170, v171, 18, v170
  s_lshl_b32 s54, s33, 14
  s_lshl_b32 s55, s34, 11
  s_add_u32 s54, s54, s55
  s_add_u32 s54, s54, 4096
  v_add_u32 v170, s54, v170
  s_add_u32 s70, s70, 16
  s_cmp_eq_u32 s60, 0
  s_cselect_b32 s50, s12, s22
  s_cselect_b32 s51, s13, s23
  s_lshl_b32 s54, s61, 17
  s_lshl_b32 s55, s30, 15
  s_add_u32 s54, s54, s55
  s_lshl_b32 s55, s62, 8
  s_add_u32 s54, s54, s55
  s_add_u32 s50, s50, s54
  s_addc_u32 s51, s51, 0
  v_lshlrev_b32 v168, 1, v3
  v_xor_b32 v168, v2, v168
  v_lshlrev_b32 v168, 4, v168
  v_lshl_add_u32 v168, v3, 10, v168
  v_xor_b32 v169, 0x80, v168
  s_lshl_b32 s56, s30, 13
  s_add_u32 s56, s56, 98304
  s_add_u32 m0, s56, 0
  s_nop 0
  global_load_lds_dwordx4 v168, s[50:51] nt
  s_add_u32 m0, s56, 1024
  s_add_u32 s50, s50, 4096
  s_addc_u32 s51, s51, 0
  global_load_lds_dwordx4 v168, s[50:51] nt
  s_add_u32 m0, s56, 2048
  s_add_u32 s50, s50, 4096
  s_addc_u32 s51, s51, 0
  global_load_lds_dwordx4 v169, s[50:51] nt
  s_add_u32 m0, s56, 3072
  s_add_u32 s50, s50, 4096
  s_addc_u32 s51, s51, 0
  global_load_lds_dwordx4 v169, s[50:51] nt
  s_add_u32 m0, s56, 4096
  s_add_u32 s50, s50, 4096
  s_addc_u32 s51, s51, 0
  global_load_lds_dwordx4 v168, s[50:51] nt
  s_add_u32 m0, s56, 5120
  s_add_u32 s50, s50, 4096
  s_addc_u32 s51, s51, 0
  global_load_lds_dwordx4 v168, s[50:51] nt
  s_add_u32 m0, s56, 6144
  s_add_u32 s50, s50, 4096
  s_addc_u32 s51, s51, 0
  global_load_lds_dwordx4 v169, s[50:51] nt
  s_add_u32 m0, s56, 7168
  s_add_u32 s50, s50, 4096
  s_addc_u32 s51, s51, 0
  global_load_lds_dwordx4 v169, s[50:51] nt
  global_load_dwordx4 v[172:175], v170, s[28:29] sc1
  global_load_dwordx4 v[176:179], v170, s[28:29] offset:16 sc1
  s_lshl_b32 s54, s70, 12
  s_add_u32 s50, s38, s54
  s_addc_u32 s51, s39, 0
  s_mov_b32 m0, s72
  s_add_u32 s72, s72, 8192
  global_load_lds_dwordx4 v4, s[50:51] offset:0 nt
  global_load_lds_dwordx4 v5, s[50:51] offset:1024 nt
  global_load_lds_dwordx4 v6, s[50:51] offset:2048 nt
  global_load_lds_dwordx4 v7, s[50:51] offset:3072 nt
  s_cmp_ge_u32 s72, s80
  s_cselect_b32 s54, 24576, 0
  s_sub_u32 s72, s72, s54
  v_and_b32 v197, 3, v1
  v_lshlrev_b32 v197, 8, v197
  v_lshl_add_u32 v197, v3, 4, v197
  v_add_u32 v197, 139264, v197
  v_mov_b32 v96, 0
  v_mov_b32 v97, 0
  v_mov_b32 v98, 0
  v_mov_b32 v99, 0
  v_mov_b32 v100, 0
  v_mov_b32 v101, 0
  v_mov_b32 v102, 0
  v_mov_b32 v103, 0
  v_mov_b32 v104, 0
  v_mov_b32 v105, 0
  v_mov_b32 v106, 0
  v_mov_b32 v107, 0
  v_mov_b32 v108, 0
  v_mov_b32 v109, 0
  v_mov_b32 v110, 0
  v_mov_b32 v111, 0
  v_mov_b32 v112, 0
  v_mov_b32 v113, 0
  v_mov_b32 v114, 0
  v_mov_b32 v115, 0
  v_mov_b32 v116, 0
  v_mov_b32 v117, 0
  v_mov_b32 v118, 0
  v_mov_b32 v119, 0
  v_mov_b32 v120, 0
  v_mov_b32 v121, 0
  v_mov_b32 v122, 0
  v_mov_b32 v123, 0
  v_mov_b32 v124, 0
  v_mov_b32 v125, 0
  v_mov_b32 v126, 0
  v_mov_b32 v127, 0
  v_mov_b32 v160, 0xff000000
  v_mov_b32 v161, 0
  s_mov_b32 s66, 0
  s_mov_b32 s67, 3
  s_mov_b32 s68, -1
  s_mov_b32 s74, 0
  s_mov_b32 s76, 4
  s_mov_b32 s77, 0
  s_mov_b32 s79, 0
  s_mov_b32 s59, 0
  s_waitcnt vmcnt(4)
  v_xor_b32 v88, v172, v188
  v_xor_b32 v89, v173, v189
  v_xor_b32 v90, v174, v190
  v_or3_b32 v88, v88, v89, v90
  v_xor_b32 v89, v175, v191
  v_xor_b32 v90, v176, v192
  v_or3_b32 v88, v88, v89, v90
  v_xor_b32 v89, v177, v193
  v_xor_b32 v90, v178, v194
  v_or3_b32 v88, v88, v89, v90
  v_xor_b32 v89, v179, v195
  v_or_b32 v88, v88, v89
  v_and_b32 v88, 31, v88
  v_cmp_ne_u32 vcc, 0, v88
  s_cbranch_vccnz L_cp1_5
  s_lshl_b32 s54, s70, 12
  s_add_u32 s50, s40, s54
  s_addc_u32 s51, s41, 0
  s_mov_b32 m0, s73
  s_add_u32 s73, s73, 8192
  global_load_lds_dwordx4 v8, s[50:51] offset:0 nt
  global_load_lds_dwordx4 v9, s[50:51] offset:1024 nt
  global_load_lds_dwordx4 v8, s[50:51] offset:2048 nt
  global_load_lds_dwordx4 v9, s[50:51] offset:3072 nt
  s_cmp_ge_u32 s73, s80
  s_cselect_b32 s54, 24576, 0
  s_sub_u32 s73, s73, s54
  s_branch L_qok_3
L_cp1_5:
  global_load_dwordx4 v[172:175], v170, s[28:29] sc1
  global_load_dwordx4 v[176:179], v170, s[28:29] offset:16 sc1
  s_lshl_b32 s54, s70, 12
  s_add_u32 s50, s40, s54
  s_addc_u32 s51, s41, 0
  s_mov_b32 m0, s73
  s_add_u32 s73, s73, 8192
  global_load_lds_dwordx4 v8, s[50:51] offset:0 nt
  global_load_lds_dwordx4 v9, s[50:51] offset:1024 nt
  global_load_lds_dwordx4 v8, s[50:51] offset:2048 nt
  global_load_lds_dwordx4 v9, s[50:51] offset:3072 nt
  s_cmp_ge_u32 s73, s80
  s_cselect_b32 s54, 24576, 0
  s_sub_u32 s73, s73, s54
  s_waitcnt vmcnt(4)
  v_xor_b32 v88, v172, v188
  v_xor_b32 v89, v173, v189
  v_xor_b32 v90, v174, v190
  v_or3_b32 v88, v88, v89, v90
  v_xor_b32 v89, v175, v191
  v_xor_b32 v90, v176, v192
  v_or3_b32 v88, v88, v89, v90
  v_xor_b32 v89, v177, v193
  v_xor_b32 v90, v178, v194
  v_or3_b32 v88, v88, v89, v90
  v_xor_b32 v89, v179, v195
  v_or_b32 v88, v88, v89
  v_and_b32 v88, 31, v88
  v_cmp_ne_u32 vcc, 0, v88
  s_cbranch_vccz L_qok_3
L_qpoll_4:
  s_add_u32 s59, s59, 1
  s_cmp_gt_u32 s59, 20000
  s_cbranch_scc1 L_end
  global_load_dwordx4 v[172:175], v170, s[28:29] sc1
  global_load_dwordx4 v[176:179], v170, s[28:29] offset:16 sc1
  s_waitcnt vmcnt(0)
  v_xor_b32 v88, v172, v188
  v_xor_b32 v89, v173, v189
  v_xor_b32 v90, v174, v190
  v_or3_b32 v88, v88, v89, v90
  v_xor_b32 v89, v175, v191
  v_xor_b32 v90, v176, v192
  v_or3_b32 v88, v88, v89, v90
  v_xor_b32 v89, v177, v193
  v_xor_b32 v90, v178, v194
  v_or3_b32 v88, v88, v89, v90
  v_xor_b32 v89, v179, v195
  v_or_b32 v88, v88, v89
  v_and_b32 v88, 31, v88
  v_cmp_ne_u32 vcc, 0, v88
  s_cbranch_vccnz L_qpoll_4
L_qok_3:
  v_mov_b32 v91, 0xffffffe0
  v_and_b32 v172, v91, v172
  v_and_b32 v173, v91, v173
  v_and_b32 v174, v91, v174
  v_and_b32 v175, v91, v175
  v_and_b32 v176, v91, v176
  v_and_b32 v177, v91, v177
  v_and_b32 v178, v91, v178
  v_and_b32 v179, v91, v179
  v_and_b32 v90, 1, v0
  v_cmp_eq_u32 vcc, 1, v90
  v_add_f32_dpp v180, v172, v172 quad_perm:[1,0,3,2] row_mask:0xf bank_mask:0xf
  v_add_f32_dpp v181, v173, v173 quad_perm:[1,0,3,2] row_mask:0xf bank_mask:0xf
  v_add_f32_dpp v182, v174, v174 quad_perm:[1,0,3,2] row_mask:0xf bank_mask:0xf
  v_add_f32_dpp v183, v175, v175 quad_perm:[1,0,3,2] row_mask:0xf bank_mask:0xf
  v_add_f32_dpp v184, v176, v176 quad_perm:[1,0,3,2] row_mask:0xf bank_mask:0xf
  v_add_f32_dpp v185, v177, v177 quad_perm:[1,0,3,2] row_mask:0xf bank_mask:0xf
  v_add_f32_dpp v186, v178, v178 quad_perm:[1,0,3,2] row_mask:0xf bank_mask:0xf
  v_add_f32_dpp v187, v179, v179 quad_perm:[1,0,3,2] row_mask:0xf bank_mask:0xf
  v_cvt_pk_bf16_f32 v180, v180, v181
  v_cvt_pk_bf16_f32 v181, v182, v183
  v_cvt_pk_bf16_f32 v182, v184, v185
  v_cvt_pk_bf16_f32 v183, v186, v187
  v_cndmask_b32 v176, v180, v182, vcc
  v_cndmask_b32 v177, v181, v183, vcc
  v_lshlrev_b32 v171, 3, v0
  v_add_u32 v171, 139264, v171
  ds_write_b64 v171, v[176:177]
  s_waitcnt lgkmcnt(0)
  s_barrier
  s_add_u32 s69, s70, 16
  s_cmp_lt_u32 s69, 576
  s_cbranch_scc1 L_statid_7
  s_mov_b32 s69, 1
  s_atomic_add s69, s[46:47], 0x0 glc
L_statid_7:
  ds_read_b128 v[24:27], v197 offset:1024
  ds_read_b128 v[28:31], v197 offset:1088
  ds_read_b128 v[32:35], v197 offset:1152
  ds_read_b128 v[36:39], v197 offset:1216
  ds_read_b128 v[40:43], v197 offset:0
  ds_read_b128 v[44:47], v197 offset:64
  ds_read_b128 v[48:51], v197 offset:128
  ds_read_b128 v[52:55], v197 offset:192
  s_waitcnt lgkmcnt(4)
L_step_8:
  s_cmp_ge_u32 s66, s67
  s_cbranch_scc1 L_exit_9
  s_cmp_eq_u32 s66, s68
  s_cbranch_scc1 L_switch_10
L_swback_11:
  s_sub_u32 s55, s67, s66
  s_waitcnt vmcnt(20)
  s_cmp_ge_u32 s55, 3
  s_cbranch_scc1 L_doneK_21
  s_waitcnt vmcnt(12)
  s_cmp_ge_u32 s55, 2
  s_cbranch_scc1 L_doneK_21
  s_waitcnt vmcnt(4)
L_doneK_21:
  ds_read_b128 v[56:59], v10
  ds_read_b128 v[60:63], v11
  ds_read_b128 v[64:67], v12
  ds_read_b128 v[68:71], v13
  s_mov_b32 s78, 0
  s_waitcnt lgkmcnt(0)
  v_mfma_f32_16x16x32_bf16 v[88:91], v[56:59], v[24:27], 0
  v_mfma_f32_16x16x32_bf16 v[88:91], v[60:63], v[28:31], v[88:91]
  v_mfma_f32_16x16x32_bf16 v[88:91], v[64:67], v[32:35], v[88:91]
  v_mfma_f32_16x16x32_bf16 v[88:91], v[68:71], v[36:39], v[88:91]
  s_cmp_eq_u32 s66, s76
  s_cbranch_scc1 L_shrink_24
L_noshr_25:
  s_cmp_lg_u32 s77, 0
  s_cbranch_scc1 L_noissA_16
  s_cmp_ge_u32 s69, 640
  s_cbranch_scc1 L_exh_18
  s_cmp_ge_u32 s67, 640
  s_cbranch_scc1 L_exh_18
  s_mov_b32 s70, s69
  s_add_u32 s69, s70, 16
  s_cmp_lt_u32 s69, 576
  s_cbranch_scc1 L_statid_26
  s_mov_b32 s69, 1
  s_atomic_add s69, s[46:47], 0x0 glc
L_statid_26:
  s_cmp_ge_u32 s70, 512
  s_cselect_b32 s54, s67, -1
  s_min_u32 s68, s68, s54
  s_add_u32 s67, s67, 1
  s_mov_b32 s78, 1
  s_cmp_ge_u32 s70, 512
  s_cselect_b32 s50, s42, s38
  s_cselect_b32 s51, s43, s39
  s_lshl_b32 s54, s70, 12
  s_add_u32 s50, s50, s54
  s_addc_u32 s51, s51, 0
  s_mov_b32 m0, s72
  s_add_u32 s72, s72, 8192
  global_load_lds_dwordx4 v4, s[50:51] offset:0 nt
  global_load_lds_dwordx4 v5, s[50:51] offset:1024 nt
  global_load_lds_dwordx4 v6, s[50:51] offset:2048 nt
  global_load_lds_dwordx4 v7, s[50:51] offset:3072 nt
  s_cmp_ge_u32 s72, s80
  s_cselect_b32 s54, 24576, 0
  s_sub_u32 s72, s72, s54
L_noissA_16:
  s_lshl_b32 s54, s55, 1
  s_add_u32 s54, s54, s78
  s_waitcnt vmcnt(20)
  s_cmp_ge_u32 s54, 7
  s_cbranch_scc1 L_doneV_23
  s_waitcnt vmcnt(16)
  s_cmp_ge_u32 s54, 6
  s_cbranch_scc1 L_doneV_23
  s_waitcnt vmcnt(12)
  s_cmp_ge_u32 s54, 5
  s_cbranch_scc1 L_doneV_23
  s_waitcnt vmcnt(8)
  s_cmp_ge_u32 s54, 4
  s_cbranch_scc1 L_doneV_23
  s_waitcnt vmcnt(4)
  s_cmp_ge_u32 s54, 3
  s_cbranch_scc1 L_doneV_23
  s_waitcnt vmcnt(0)
L_doneV_23:
  ds_read_b64_tr_b16 v[72:73], v14
  ds_read_b64_tr_b16 v[74:75], v15
  ds_read_b64_tr_b16 v[76:77], v16
  ds_read_b64_tr_b16 v[78:79], v17
  ds_read_b64_tr_b16 v[80:81], v18
  ds_read_b64_tr_b16 v[82:83], v19
  ds_read_b64_tr_b16 v[84:85], v20
  ds_read_b64_tr_b16 v[86:87], v21
  ds_read_b32 v198, v14
  v_cvt_pk_bf16_f32 v168, v88, v89
  v_cvt_pk_bf16_f32 v169, v90, v91
  v_lshlrev_b32 v164, 16, v168
  v_and_b32 v165, v199, v168
  v_lshlrev_b32 v166, 16, v169
  v_and_b32 v167, v199, v169
  v_mul_f32 v164, s57, v164
  v_mul_f32 v165, s57, v165
  v_mul_f32 v166, s57, v166
  v_mul_f32 v167, s57, v167
  v_cvt_pk_bf16_f32 v168, v164, v165
  v_cvt_pk_bf16_f32 v169, v166, v167
  v_lshlrev_b32 v164, 16, v168
  v_and_b32 v165, v199, v168
  v_lshlrev_b32 v166, 16, v169
  v_and_b32 v167, v199, v169
  v_mul_f32 v164, s58, v164
  v_mul_f32 v165, s58, v165
  v_mul_f32 v166, s58, v166
  v_mul_f32 v167, s58, v167
  v_max3_f32 v170, v164, v165, v166
  v_max3_f32 v170, v170, v167, v160
  s_add_u32 s74, s74, 1
  s_cmp_eq_u32 s74, 3
  s_mov_b32 s75, 8192
  s_cselect_b32 s75, 0xffffc000, s75
  s_cselect_b32 s74, 0, s74
  s_waitcnt lgkmcnt(1)
  s_cmp_eq_u32 s78, 0
  s_cbranch_scc1 L_noissB_17
  s_cmp_ge_u32 s70, 512
  s_cselect_b32 s50, s44, s40
  s_cselect_b32 s51, s45, s41
  s_lshl_b32 s54, s70, 12
  s_add_u32 s50, s50, s54
  s_addc_u32 s51, s51, 0
  s_mov_b32 m0, s73
  s_add_u32 s73, s73, 8192
  global_load_lds_dwordx4 v8, s[50:51] offset:0 nt
  global_load_lds_dwordx4 v9, s[50:51] offset:1024 nt
  global_load_lds_dwordx4 v8, s[50:51] offset:2048 nt
  global_load_lds_dwordx4 v9, s[50:51] offset:3072 nt
  s_cmp_ge_u32 s73, s80
  s_cselect_b32 s54, 24576, 0
  s_sub_u32 s73, s73, s54
L_noissB_17:
  v_mov_b32 v171, v170
  v_add_u32 v10, s75, v10
  v_add_u32 v11, s75, v11
  v_permlane16_swap_b32 v170, v171
  v_max_f32 v170, v170, v171
  v_mov_b32 v171, v170
  v_add_u32 v12, s75, v12
  v_add_u32 v13, s75, v13
  v_permlane32_swap_b32 v170, v171
  v_max_f32 v170, v170, v171
  v_cmp_gt_f32 vcc, v170, v160
  s_cbranch_vccz L_noresc_27
  v_sub_f32 v171, v160, v170
  v_exp_f32 v171, v171
  v_mov_b32 v160, v170
  v_mul_f32 v161, v161, v171
  v_mul_f32 v96, v96, v171
  v_mul_f32 v97, v97, v171
  v_mul_f32 v98, v98, v171
  v_mul_f32 v99, v99, v171
  v_mul_f32 v100, v100, v171
  v_mul_f32 v101, v101, v171
  v_mul_f32 v102, v102, v171
  v_mul_f32 v103, v103, v171
  v_mul_f32 v104, v104, v171
  v_mul_f32 v105, v105, v171
  v_mul_f32 v106, v106, v171
  v_mul_f32 v107, v107, v171
  v_mul_f32 v108, v108, v171
  v_mul_f32 v109, v109, v171
  v_mul_f32 v110, v110, v171
  v_mul_f32 v111, v111, v171
  v_mul_f32 v112, v112, v171
  v_mul_f32 v113, v113, v171
  v_mul_f32 v114, v114, v171
  v_mul_f32 v115, v115, v171
  v_mul_f32 v116, v116, v171
  v_mul_f32 v117, v117, v171
  v_mul_f32 v118, v118, v171
  v_mul_f32 v119, v119, v171
  v_mul_f32 v120, v120, v171
  v_mul_f32 v121, v121, v171
  v_mul_f32 v122, v122, v171
  v_mul_f32 v123, v123, v171
  v_mul_f32 v124, v124, v171
  v_mul_f32 v125, v125, v171
  v_mul_f32 v126, v126, v171
  v_mul_f32 v127, v127, v171
L_noresc_27:
  v_sub_f32 v164, v164, v160
  v_sub_f32 v165, v165, v160
  v_sub_f32 v166, v166, v160
  v_sub_f32 v167, v167, v160
  v_exp_f32 v164, v164
  v_exp_f32 v165, v165
  v_exp_f32 v166, v166
  v_exp_f32 v167, v167
  s_add_u32 s66, s66, 1
  v_cvt_pk_bf16_f32 v92, v164, v165
  v_cvt_pk_bf16_f32 v93, v166, v167
  v_add_f32 v164, v164, v165
  v_add_f32 v166, v166, v167
  v_mfma_f32_16x16x16_bf16 v[96:99], v[72:73], v[92:93], v[96:99]
  v_add_f32 v164, v164, v166
  v_add_u32 v14, s75, v14
  v_mfma_f32_16x16x16_bf16 v[100:103], v[74:75], v[92:93], v[100:103]
  v_add_f32 v161, v161, v164
  v_add_u32 v15, s75, v15
  v_mfma_f32_16x16x16_bf16 v[104:107], v[76:77], v[92:93], v[104:107]
  v_add_u32 v16, s75, v16
  v_mfma_f32_16x16x16_bf16 v[108:111], v[78:79], v[92:93], v[108:111]
  v_add_u32 v17, s75, v17
  v_mfma_f32_16x16x16_bf16 v[112:115], v[80:81], v[92:93], v[112:115]
  v_add_u32 v18, s75, v18
  v_mfma_f32_16x16x16_bf16 v[116:119], v[82:83], v[92:93], v[116:119]
  v_add_u32 v19, s75, v19
  v_mfma_f32_16x16x16_bf16 v[120:123], v[84:85], v[92:93], v[120:123]
  v_add_u32 v20, s75, v20
  v_mfma_f32_16x16x16_bf16 v[124:127], v[86:87], v[92:93], v[124:127]
  v_add_u32 v21, s75, v21
  s_branch L_step_8
L_shrink_24:
  s_add_u32 s76, s76, 4
  s_cmp_gt_u32 s55, 1
  s_cbranch_scc1 L_noissA_16
  s_branch L_noshr_25
L_exh_18:
  s_mov_b32 s77, 1
  s_branch L_noissA_16
L_switch_10:
  s_nop 7
  v_mov_b32 v128, v96
  v_mov_b32 v96, 0
  v_mov_b32 v129, v97
  v_mov_b32 v97, 0
  v_mov_b32 v130, v98
  v_mov_b32 v98, 0
  v_mov_b32 v131, v99
  v_mov_b32 v99, 0
  v_mov_b32 v132, v100
  v_mov_b32 v100, 0
  v_mov_b32 v133, v101
  v_mov_b32 v101, 0
  v_mov_b32 v134, v102
  v_mov_b32 v102, 0
  v_mov_b32 v135, v103
  v_mov_b32 v103, 0
  v_mov_b32 v136, v104
  v_mov_b32 v104, 0
  v_mov_b32 v137, v105
  v_mov_b32 v105, 0
  v_mov_b32 v138, v106
  v_mov_b32 v106, 0
  v_mov_b32 v139, v107
  v_mov_b32 v107, 0
  v_mov_b32 v140, v108
  v_mov_b32 v108, 0
  v_mov_b32 v141, v109
  v_mov_b32 v109, 0
  v_mov_b32 v142, v110
  v_mov_b32 v110, 0
  v_mov_b32 v143, v111
  v_mov_b32 v111, 0
  v_mov_b32 v144, v112
  v_mov_b32 v112, 0
  v_mov_b32 v145, v113
  v_mov_b32 v113, 0
  v_mov_b32 v146, v114
  v_mov_b32 v114, 0
  v_mov_b32 v147, v115
  v_mov_b32 v115, 0
  v_mov_b32 v148, v116
  v_mov_b32 v116, 0
  v_mov_b32 v149, v117
  v_mov_b32 v117, 0
  v_mov_b32 v150, v118
  v_mov_b32 v118, 0
  v_mov_b32 v151, v119
  v_mov_b32 v119, 0
  v_mov_b32 v152, v120
  v_mov_b32 v120, 0
  v_mov_b32 v153, v121
  v_mov_b32 v121, 0
  v_mov_b32 v154, v122
  v_mov_b32 v122, 0
  v_mov_b32 v155, v123
  v_mov_b32 v123, 0
  v_mov_b32 v156, v124
  v_mov_b32 v124, 0
  v_mov_b32 v157, v125
  v_mov_b32 v125, 0
  v_mov_b32 v158, v126
  v_mov_b32 v126, 0
  v_mov_b32 v159, v127
  v_mov_b32 v127, 0
  v_mov_b32 v162, v160
  v_mov_b32 v163, v161
  v_mov_b32 v160, 0xff000000
  v_mov_b32 v161, 0
  v_mov_b32 v24, v40
  v_mov_b32 v25, v41
  v_mov_b32 v26, v42
  v_mov_b32 v27, v43
  v_mov_b32 v28, v44
  v_mov_b32 v29, v45
  v_mov_b32 v30, v46
  v_mov_b32 v31, v47
  v_mov_b32 v32, v48
  v_mov_b32 v33, v49
  v_mov_b32 v34, v50
  v_mov_b32 v35, v51
  v_mov_b32 v36, v52
  v_mov_b32 v37, v53
  v_mov_b32 v38, v54
  v_mov_b32 v39, v55
  s_mov_b32 s79, 1
  s_cmp_eq_u32 s66, s67
  s_cbranch_scc0 L_swback_11
  s_branch L_tail_28
L_exit_9:
  s_cmp_eq_u32 s79, 0
  s_cbranch_scc1 L_switch_10
L_tail_28:
  s_waitcnt lgkmcnt(0)
  s_nop 5
  v_mov_b32 v164, v161
  v_mov_b32 v165, v163
  v_mov_b32 v168, v160
  v_permlane16_swap_b32 v161, v164
  v_permlane16_swap_b32 v163, v165
  v_add_f32 v161, v161, v164
  v_add_f32 v163, v163, v165
  v_mov_b32 v164, v161
  v_mov_b32 v165, v163
  v_mov_b32 v170, v162
  v_permlane32_swap_b32 v161, v164
  v_permlane32_swap_b32 v163, v165
  v_cmp_gt_u32 vcc, 4, v2
  v_add_f32 v169, v161, v164
  v_add_f32 v171, v163, v165
  s_and_saveexec_b64 s[64:65], vcc
  ds_write_b128 v209, v[96:99] offset:0
  ds_write_b128 v209, v[100:103] offset:64
  ds_write_b128 v209, v[104:107] offset:128
  ds_write_b128 v209, v[108:111] offset:192
  ds_write_b128 v209, v[112:115] offset:256
  ds_write_b128 v209, v[116:119] offset:320
  ds_write_b128 v209, v[120:123] offset:384
  ds_write_b128 v209, v[124:127] offset:448
  ds_write_b128 v209, v[128:131] offset:2112
  ds_write_b128 v209, v[132:135] offset:2176
  ds_write_b128 v209, v[136:139] offset:2240
  ds_write_b128 v209, v[140:143] offset:2304
  ds_write_b128 v209, v[144:147] offset:2368
  ds_write_b128 v209, v[148:151] offset:2432
  ds_write_b128 v209, v[152:155] offset:2496
  ds_write_b128 v209, v[156:159] offset:2560
  ds_write_b64 v210, v[168:169]
  ds_write_b64 v210, v[170:171] offset:32
  s_mov_b64 exec, s[64:65]
  s_waitcnt lgkmcnt(0)
  s_barrier
  ds_read_b64 v[112:113], v213 offset:0
  ds_read_b64 v[114:115], v213 offset:24576
  ds_read_b64 v[116:117], v213 offset:49152
  ds_read_b64 v[118:119], v214
  ds_read_b128 v[96:99], v211 offset:0
  ds_read_b128 v[100:103], v211 offset:24576
  ds_read_b128 v[104:107], v211 offset:49152
  ds_read_b128 v[108:111], v212
  s_waitcnt lgkmcnt(4)
  v_max3_f32 v168, v112, v114, v116
  v_max_f32 v168, v168, v118
  v_sub_f32 v176, v112, v168
  v_sub_f32 v177, v114, v168
  v_sub_f32 v178, v116, v168
  v_sub_f32 v179, v118, v168
  v_exp_f32 v176, v176
  v_exp_f32 v177, v177
  v_exp_f32 v178, v178
  v_exp_f32 v179, v179
  s_nop 0
  v_mul_f32 v169, v176, v113
  v_fma_f32 v169, v177, v115, v169
  v_fma_f32 v169, v178, v117, v169
  v_fma_f32 v169, v179, v119, v169
  v_max_f32 v169, 0x0da24260, v169
  v_rcp_f32 v170, v169
  v_log_f32 v171, v169
  s_waitcnt lgkmcnt(0)
  v_mul_f32 v176, v176, v170
  v_mul_f32 v177, v177, v170
  v_mul_f32 v178, v178, v170
  v_mul_f32 v179, v179, v170
  v_add_f32 v171, v171, v168
  v_mul_f32 v180, v176, v96
  v_mul_f32 v181, v176, v97
  v_mul_f32 v182, v176, v98
  v_mul_f32 v183, v176, v99
  v_fma_f32 v180, v177, v100, v180
  v_fma_f32 v181, v177, v101, v181
  v_fma_f32 v182, v177, v102, v182
  v_fma_f32 v183, v177, v103, v183
  v_fma_f32 v180, v178, v104, v180
  v_fma_f32 v181, v178, v105, v181
  v_fma_f32 v182, v178, v106, v182
  v_fma_f32 v183, v178, v107, v183
  v_fma_f32 v180, v179, v108, v180
  v_fma_f32 v181, v179, v109, v181
  v_fma_f32 v182, v179, v110, v182
  v_fma_f32 v183, v179, v111, v183
  v_cvt_pk_bf16_f32 v172, v180, v181
  v_cvt_pk_bf16_f32 v173, v182, v183
  v_and_or_b32 v174, v171, v199, v205
  v_lshl_or_b32 v175, v171, 16, v206
  v_lshl_or_b32 v180, v172, 16, v205
  v_and_or_b32 v181, v172, v199, v206
  v_lshl_or_b32 v182, v173, 16, v207
  v_and_or_b32 v183, v173, v199, v208
  v_and_b32 v177, 31, v0
  v_cmp_eq_u32 vcc, 0, v177
  global_store_dwordx4 v215, v[180:183], s[28:29] sc1
  s_and_saveexec_b64 s[64:65], vcc
  global_store_dwordx2 v216, v[174:175], s[28:29] sc1
  s_mov_b64 exec, s[64:65]
  ds_read_b64_tr_b16 v[128:129], v218 offset:0
  ds_read_b64_tr_b16 v[130:131], v218 offset:1024
  ds_read_b64_tr_b16 v[132:133], v218 offset:8192
  ds_read_b64_tr_b16 v[134:135], v218 offset:9216
  ds_read_b64_tr_b16 v[136:137], v218 offset:16384
  ds_read_b64_tr_b16 v[138:139], v218 offset:17408
  ds_read_b64_tr_b16 v[140:141], v218 offset:24576
  ds_read_b64_tr_b16 v[142:143], v218 offset:25600
  ds_read_b64_tr_b16 v[144:145], v219 offset:0
  ds_read_b64_tr_b16 v[146:147], v219 offset:1024
  ds_read_b64_tr_b16 v[148:149], v219 offset:8192
  ds_read_b64_tr_b16 v[150:151], v219 offset:9216
  ds_read_b64_tr_b16 v[152:153], v219 offset:16384
  ds_read_b64_tr_b16 v[154:155], v219 offset:17408
  ds_read_b64_tr_b16 v[156:157], v219 offset:24576
  ds_read_b64_tr_b16 v[158:159], v219 offset:25600
  s_waitcnt vmcnt(0)
  s_mov_b32 s59, 0
L_p1_29:
  global_load_dwordx2 v[112:113], v217, s[28:29] offset:0 sc1
  global_load_dwordx2 v[114:115], v217, s[28:29] offset:256 sc1
  global_load_dwordx2 v[116:117], v217, s[28:29] offset:512 sc1
  global_load_dwordx2 v[118:119], v217, s[28:29] offset:768 sc1
  global_load_dwordx4 v[96:99], v220, s[28:29] sc1
  global_load_dwordx4 v[100:103], v220, s[28:29] offset:2048 sc1
  global_load_dwordx4 v[104:107], v221, s[28:29] sc1
  global_load_dwordx4 v[108:111], v221, s[28:29] offset:2048 sc1
  s_waitcnt vmcnt(4)
  v_xor_b32 v175, v112, v205
  v_xor_b32 v171, v113, v206
  v_xor_b32 v174, v114, v205
  v_or3_b32 v175, v175, v171, v174
  v_xor_b32 v171, v115, v206
  v_xor_b32 v174, v116, v205
  v_or3_b32 v175, v175, v171, v174
  v_xor_b32 v171, v117, v206
  v_xor_b32 v174, v118, v205
  v_or3_b32 v175, v175, v171, v174
  v_xor_b32 v171, v119, v206
  v_or_b32 v175, v175, v171
  s_waitcnt vmcnt(0)
  v_xor_b32 v170, v96, v205
  v_xor_b32 v171, v97, v206
  v_xor_b32 v174, v98, v207
  v_or3_b32 v170, v170, v171, v174
  v_xor_b32 v171, v99, v208
  v_xor_b32 v174, v100, v205
  v_or3_b32 v170, v170, v171, v174
  v_xor_b32 v171, v101, v206
  v_xor_b32 v174, v102, v207
  v_or3_b32 v170, v170, v171, v174
  v_xor_b32 v171, v103, v208
  v_xor_b32 v174, v104, v205
  v_or3_b32 v170, v170, v171, v174
  v_xor_b32 v171, v105, v206
  v_xor_b32 v174, v106, v207
  v_or3_b32 v170, v170, v171, v174
  v_xor_b32 v171, v107, v208
  v_xor_b32 v174, v108, v205
  v_or3_b32 v170, v170, v171, v174
  v_xor_b32 v171, v109, v206
  v_xor_b32 v174, v110, v207
  v_or3_b32 v170, v170, v171, v174
  v_xor_b32 v171, v111, v208
  v_or_b32 v170, v170, v171
  v_or_b32 v170, v170, v175
  v_and_b32 v170, 0xffff, v170
  v_cmp_ne_u32 vcc, 0, v170
  s_and_b64 exec, exec, vcc
  s_cbranch_scc0 L_p1ok_30
  s_add_u32 s59, s59, 1
  s_cmp_gt_u32 s59, 20000
  s_cbranch_scc1 L_end
  s_branch L_p1_29
L_p1ok_30:
  s_mov_b64 exec, -1
  s_mov_b32 s54, 0x07060302
  v_perm_b32 v176, v112, v113, s54
  v_perm_b32 v177, v114, v115, s54
  v_perm_b32 v178, v116, v117, s54
  v_perm_b32 v179, v118, v119, s54
  v_max3_f32 v168, v176, v177, v178
  v_max_f32 v168, v168, v179
  v_sub_f32 v176, v176, v168
  v_sub_f32 v177, v177, v168
  v_sub_f32 v178, v178, v168
  v_sub_f32 v179, v179, v168
  v_exp_f32 v176, v176
  v_exp_f32 v177, v177
  v_exp_f32 v178, v178
  v_exp_f32 v179, v179
  v_and_b32 v96, v199, v96
  v_and_b32 v97, v199, v97
  v_and_b32 v98, v199, v98
  v_and_b32 v99, v199, v99
  v_and_b32 v100, v199, v100
  v_and_b32 v101, v199, v101
  v_and_b32 v102, v199, v102
  v_and_b32 v103, v199, v103
  v_and_b32 v104, v199, v104
  v_and_b32 v105, v199, v105
  v_and_b32 v106, v199, v106
  v_and_b32 v107, v199, v107
  v_and_b32 v108, v199, v108
  v_and_b32 v109, v199, v109
  v_and_b32 v110, v199, v110
  v_and_b32 v111, v199, v111
  v_add_f32 v169, v176, v177
  v_add_f32 v170, v178, v179
  v_add_f32 v169, v169, v170
  v_rcp_f32 v169, v169
  v_mul_f32 v180, v176, v96
  v_mul_f32 v181, v176, v97
  v_mul_f32 v182, v176, v98
  v_mul_f32 v183, v176, v99
  v_fma_f32 v180, v177, v100, v180
  v_fma_f32 v181, v177, v101, v181
  v_fma_f32 v182, v177, v102, v182
  v_fma_f32 v183, v177, v103, v183
  v_fma_f32 v180, v178, v104, v180
  v_fma_f32 v181, v178, v105, v181
  v_fma_f32 v182, v178, v106, v182
  v_fma_f32 v183, v178, v107, v183
  v_fma_f32 v180, v179, v108, v180
  v_fma_f32 v181, v179, v109, v181
  v_fma_f32 v182, v179, v110, v182
  v_fma_f32 v183, v179, v111, v183
  v_mul_f32 v180, v180, v169
  v_mul_f32 v181, v181, v169
  v_mul_f32 v182, v182, v169
  v_mul_f32 v183, v183, v169
  v_cvt_pk_bf16_f32 v184, v180, v181
  v_cvt_pk_bf16_f32 v185, v182, v183
  ds_write_b64 v222, v[184:185]
  s_waitcnt lgkmcnt(0)
  s_barrier
  ds_read_b128 v[56:59], v223 offset:0
  ds_read_b128 v[60:63], v223 offset:64
  ds_read_b128 v[64:67], v223 offset:128
  ds_read_b128 v[68:71], v223 offset:192
  v_cmp_lt_u32 vcc, 7, v2
  s_waitcnt lgkmcnt(3)
  v_mfma_f32_16x16x32_bf16 v[172:175], v[128:131], v[56:59], 0
  v_mfma_f32_16x16x32_bf16 v[176:179], v[144:147], v[56:59], 0
  s_waitcnt lgkmcnt(2)
  v_mfma_f32_16x16x32_bf16 v[172:175], v[132:135], v[60:63], v[172:175]
  v_mfma_f32_16x16x32_bf16 v[176:179], v[148:151], v[60:63], v[176:179]
  s_waitcnt lgkmcnt(1)
  v_mfma_f32_16x16x32_bf16 v[172:175], v[136:139], v[64:67], v[172:175]
  v_mfma_f32_16x16x32_bf16 v[176:179], v[152:155], v[64:67], v[176:179]
  s_waitcnt lgkmcnt(0)
  v_mfma_f32_16x16x32_bf16 v[172:175], v[140:143], v[68:71], v[172:175]
  v_mfma_f32_16x16x32_bf16 v[176:179], v[156:159], v[68:71], v[176:179]
  s_nop 7
  v_cndmask_b32 v172, v172, v176, vcc
  v_cndmask_b32 v173, v173, v177, vcc
  v_cndmask_b32 v174, v174, v178, vcc
  v_cndmask_b32 v175, v175, v179, vcc
  v_add_u32 v172, 0x800, v172
  v_add_u32 v173, 0x800, v173
  v_add_u32 v174, 0x800, v174
  v_add_u32 v175, 0x800, v175
  v_and_or_b32 v172, v172, v200, v201
  v_and_or_b32 v173, v173, v200, v202
  v_and_or_b32 v174, v174, v200, v203
  v_and_or_b32 v175, v175, v200, v204
  global_store_dwordx4 v224, v[172:175], s[28:29] sc1
  s_cmp_ge_u32 s30, 1
  s_cbranch_scc1 L_end
  s_waitcnt vmcnt(0)
  s_mov_b32 s59, 0
L_p2_31:
  global_load_dwordx4 v[96:99], v225, s[28:29] sc1
  global_load_dwordx4 v[100:103], v226, s[28:29] sc1
  global_load_dwordx4 v[104:107], v227, s[28:29] sc1
  global_load_dwordx4 v[108:111], v228, s[28:29] sc1
  s_waitcnt vmcnt(0)
  v_xor_b32 v170, v96, v201
  v_xor_b32 v171, v97, v202
  v_xor_b32 v180, v98, v203
  v_or3_b32 v170, v170, v171, v180
  v_xor_b32 v171, v99, v204
  v_xor_b32 v180, v100, v201
  v_or3_b32 v170, v170, v171, v180
  v_xor_b32 v171, v101, v202
  v_xor_b32 v180, v102, v203
  v_or3_b32 v170, v170, v171, v180
  v_xor_b32 v171, v103, v204
  v_xor_b32 v180, v104, v201
  v_or3_b32 v170, v170, v171, v180
  v_xor_b32 v171, v105, v202
  v_xor_b32 v180, v106, v203
  v_or3_b32 v170, v170, v171, v180
  v_xor_b32 v171, v107, v204
  v_xor_b32 v180, v108, v201
  v_or3_b32 v170, v170, v171, v180
  v_xor_b32 v171, v109, v202
  v_xor_b32 v180, v110, v203
  v_or3_b32 v170, v170, v171, v180
  v_xor_b32 v171, v111, v204
  v_or_b32 v170, v170, v171
  v_and_b32 v170, 0xfff, v170
  v_cmp_ne_u32 vcc, 0, v170
  s_and_b64 exec, exec, vcc
  s_cbranch_scc0 L_p2ok_32
  s_add_u32 s59, s59, 1
  s_cmp_gt_u32 s59, 20000
  s_cbranch_scc1 L_end
  s_branch L_p2_31
L_p2ok_32:
  s_mov_b64 exec, -1
  v_and_b32 v96, v200, v96
  v_and_b32 v97, v200, v97
  v_and_b32 v98, v200, v98
  v_and_b32 v99, v200, v99
  v_and_b32 v100, v200, v100
  v_and_b32 v101, v200, v101
  v_and_b32 v102, v200, v102
  v_and_b32 v103, v200, v103
  v_and_b32 v104, v200, v104
  v_and_b32 v105, v200, v105
  v_and_b32 v106, v200, v106
  v_and_b32 v107, v200, v107
  v_and_b32 v108, v200, v108
  v_and_b32 v109, v200, v109
  v_and_b32 v110, v200, v110
  v_and_b32 v111, v200, v111
  v_add_f32 v96, v96, v100
  v_add_f32 v104, v104, v108
  v_add_f32 v97, v97, v101
  v_add_f32 v105, v105, v109
  v_add_f32 v98, v98, v102
  v_add_f32 v106, v106, v110
  v_add_f32 v99, v99, v103
  v_add_f32 v107, v107, v111
  v_add_f32 v96, v96, v104
  v_add_f32 v97, v97, v105
  v_add_f32 v98, v98, v106
  v_add_f32 v99, v99, v107
  s_nop 1
  v_add_f32_dpp v100, v96, v96 row_ror:8 row_mask:0xf bank_mask:0xf
  v_add_f32_dpp v101, v97, v97 row_ror:8 row_mask:0xf bank_mask:0xf
  v_add_f32_dpp v102, v98, v98 row_ror:8 row_mask:0xf bank_mask:0xf
  v_add_f32_dpp v103, v99, v99 row_ror:8 row_mask:0xf bank_mask:0xf
  v_mov_b32 v104, v100
  v_mov_b32 v105, v101
  v_mov_b32 v106, v102
  v_mov_b32 v107, v103
  s_nop 1
  v_permlane16_swap_b32 v100, v104
  v_permlane16_swap_b32 v101, v105
  v_permlane16_swap_b32 v102, v106
  v_permlane16_swap_b32 v103, v107
  v_add_f32 v100, v100, v104
  v_add_f32 v101, v101, v105
  v_add_f32 v102, v102, v106
  v_add_f32 v103, v103, v107
  v_mov_b32 v104, v100
  v_mov_b32 v105, v101
  v_mov_b32 v106, v102
  v_mov_b32 v107, v103
  s_nop 1
  v_permlane32_swap_b32 v100, v104
  v_permlane32_swap_b32 v101, v105
  v_permlane32_swap_b32 v102, v106
  v_permlane32_swap_b32 v103, v107
  v_add_f32 v100, v100, v104
  v_add_f32 v101, v101, v105
  v_add_f32 v102, v102, v106
  v_add_f32 v103, v103, v107
  v_cmp_gt_u32 vcc, 8, v1
  v_cvt_pk_bf16_f32 v96, v100, v101
  v_cvt_pk_bf16_f32 v97, v102, v103
  s_and_saveexec_b64 s[64:65], vcc
  global_store_dwordx2 v229, v[96:97], s[24:25] sc1
  s_mov_b64 exec, s[64:65]
  s_or_b32 s54, s2, s30
  s_cmp_lg_u32 s54, 0
  s_cbranch_scc1 L_nobump_33
  v_mov_b32 v164, 0
  v_mov_b32 v165, s35
  v_cmp_eq_u32 vcc, 0, v1
  s_and_saveexec_b64 s[64:65], vcc
  global_store_dword v164, v165, s[28:29] sc1
  s_mov_b64 exec, s[64:65]
L_nobump_33:
L_end:
  s_endpgm
.section .rodata,"a"
.p2align 6
.amdhsa_kernel concat_heads__sliding_block_cached__gqa_block_cached__decode_kernel
.amdhsa_next_free_vgpr 232
.amdhsa_next_free_sgpr 87
.amdhsa_accum_offset 232
.amdhsa_group_segment_fixed_size 0
.amdhsa_kernarg_size 104
.amdhsa_user_sgpr_count 2
.amdhsa_user_sgpr_kernarg_segment_ptr 1
.amdhsa_system_sgpr_workgroup_id_x 1
.end_amdhsa_kernel
```
